```python
import torch

def _softmax(x, axis=-1):
    return torch.softmax(x, dim=axis)
def _gelu(x):
    return torch.nn.functional.gelu(x, approximate="tanh")
def _silu(x):
    return torch.nn.functional.silu(x)
def _sigmoid(x):
    return torch.sigmoid(x)
def _layernorm(x, axis=-1, eps=1e-5):
    m = x.mean(dim=axis, keepdim=True)
    v = x.var(dim=axis, keepdim=True, unbiased=False)
    return (x - m) / torch.sqrt(v + eps)
def _scatter_add(tgt, idx, src, axis=0):
    return tgt.clone().index_add_(axis, idx, src)
def _segment_sum(src, seg, n):
    out = torch.zeros((n,) + src.shape[1:], dtype=src.dtype)
    return out.index_add_(0, seg, src)
def _pad(x, pw):
    flat = tuple(v for pair in reversed(pw) for v in pair)
    return torch.nn.functional.pad(x, flat)

kernel_name = 'standalone__batchnorm__prompt'

def setup_inputs():

    _w = (lambda a: (lambda t: t.to(torch.bfloat16) if t.is_floating_point() else t)(torch.as_tensor(a)))
    B, S, C = 2, 2048, 448
    K = 3
    return {
        "x": _w((lambda *s: torch.randn(*s, dtype=torch.bfloat16) * 0.05)(B, S, C)),
        "w": _w((lambda *s: torch.randn(*s, dtype=torch.bfloat16) * 0.05)(K, C, C) * (1.0 / (K * C) ** 0.5)),
        "mean": _w((lambda *s: torch.randn(*s, dtype=torch.bfloat16) * 0.05)(C) * 0.1),
        "var": _w(torch.abs((lambda *s: torch.randn(*s, dtype=torch.bfloat16) * 0.05)(C)) + 0.5),
        "g": _w((lambda *s: torch.randn(*s, dtype=torch.bfloat16) * 0.05)(C) + 1.0),
        "b": _w((lambda *s: torch.randn(*s, dtype=torch.bfloat16) * 0.05)(C) * 0.1),
    }

def reference(x, w, mean, var, g, b):
    K = 3
    P = K // 2
    S = x.shape[1]
    xp = _pad(x, ((0, 0), (P, P), (0, 0)))
    y = sum(torch.einsum('bsc,cd->bsd', xp[:, k:k + S, :], w[k]) for k in range(K))
    inv_std = 1.0 / torch.sqrt(var + 1e-5)
    y = (y - mean) * (g * inv_std) + b
    return _silu(y)
```

```asm
; @launch grid=(256,1,1) block=(512,1,1) lds=124928
.amdgcn_target "amdgcn-amd-amdhsa--gfx950"
.text
.globl standalone__batchnorm__prompt_kernel
.p2align 12
.fill 832, 4, 0xbf810000
.p2align 8
.type standalone__batchnorm__prompt_kernel,@function
standalone__batchnorm__prompt_kernel:
    s_load_dwordx2 s[24:25], s[0:1], 0
    s_load_dwordx2 s[28:29], s[0:1], 8
    v_lshrrev_b32 v1, 6, v0
    s_and_b32 s4, s2, 7
    v_readfirstlane_b32 s22, v1
    s_bfe_u32 s5, s2, 0x20003
    s_lshl2_add_u32 s6, s4, s5
    s_lshl_b32 s23, s6, 7
    v_and_b32 v0, 63, v0
    s_movk_i32 s59, 896
    s_mov_b32 s26, 3670016
    s_mov_b32 s27, 0x20000
    s_sub_u32 s36, s4, 7
    s_min_u32 s36, s36, s4
    s_lshr_b32 s7, s2, 5
    s_cmp_ge_u32 s7, 7
    s_cbranch_scc0 L_work
L_helper:
    s_cmpk_ge_u32 s2, 256
    s_cbranch_scc1 L_hend
    s_cmp_ge_u32 s22, 3
    s_cbranch_scc1 L_hpar
    s_mul_i32 s3, s22, 43
    s_add_u32 s3, s3, s5
    s_add_u32 s3, s3, s23
    v_min_u32 v0, 42, v0
    v_add3_u32 v0, s3, -1, v0
    v_max_i32 v0, 0, v0
    v_mul_u32_u24 v0, s59, v0
    s_movk_i32 s38, 128
    s_movk_i32 s3, 5
    s_waitcnt lgkmcnt(0)
L_hl:
    s_add_u32 s36, s36, 1
    s_cmp_eq_u32 s36, 7
    s_cselect_b32 s36, 0, s36
    s_mul_i32 s37, s36, s38
    buffer_load_dword v1, v0, s[24:27], s37 offen
    s_sub_u32 s3, s3, 1
    s_cbranch_scc0 L_hl
L_hend:
    s_endpgm
L_hpar:
    s_cmp_lg_u32 s22, 4
    s_cbranch_scc1 L_hp2
    s_sub_u32 s3, s6, 4
    s_cbranch_scc1 L_hend
    v_min_u32 v0, 37, v0
    v_mul_u32_u24 v1, 27, v0
    v_lshrrev_b32 v1, 9, v1
    s_mul_i32 s3, s3, 19
    v_add_u32 v0, s3, v0
    v_mul_u32_u24 v0, s59, v0
    v_mul_u32_u24 v1, 16896, v1
    v_sub_u32 v0, v0, v1
    s_waitcnt lgkmcnt(0)
    buffer_load_dword v1, v0, s[24:27], 0 offen
    s_endpgm
L_work:
    s_lshl_b32 s52, s7, 7
    s_and_b32 s57, s22, 1
    s_cmp_lt_u32 s22, 4
    s_cbranch_scc0 L_consumer
    v_lshrrev_b32 v1, 3, v0
    v_and_b32 v3, 7, v0
    s_and_b32 s46, s5, 1
    s_lshl_b32 s19, s46, 2
    v_xor_b32 v7, s19, v3
    v_and_b32 v2, 6, v1
    v_xor_b32 v4, v7, v2
    s_sub_u32 s3, 0, s22
    s_and_b32 s3, s3, 3
    s_add_u32 s3, s3, s23
    v_lshl_add_u32 v5, v1, 2, s3
    v_lshlrev_b32 v4, 4, v4
    v_mad_u32_u24 v16, v5, s59, v4
    s_min_u32 s60, s22, 1
    s_lshl4_add_u32 s60, s22, s60
    s_lshl_b32 s60, s60, 8
    s_lshl_b32 s37, s36, 7
    v_and_b32 v2, 2, v1
    v_lshlrev_b32 v2, 1, v2
    v_xor_b32 v5, v3, v2
    v_lshl_add_u32 v5, v5, 4, s52
    s_lshl_b32 s61, s22, 3
    v_add_u32 v6, s61, v1
    v_mad_u32_u24 v20, v6, s59, v5
    s_lshl_b32 s62, s22, 9
    s_mul_i32 s3, s57, 11784
    s_add_u32 s62, s62, s3
    s_add_u32 s62, s62, 49920
    s_mov_b32 s30, 1204224
    s_mov_b32 s31, s27
    s_and_b32 s45, s5, 2
    s_lshl_b32 s58, s45, 12
    s_add_u32 s58, s58, s62
    s_mul_i32 s39, s45, 7
    s_add_u32 s39, s39, s36
    s_lshl1_add_u32 s39, s39, s46
    s_mul_i32 s38, s39, 28672
    s_sub_u32 s45, 1, s45
    s_mul_i32 s49, s45, 401408
    s_lshl_b32 s54, s45, 12
    s_and_b32 s48, s6, 15
    s_add_u32 s47, s23, 0x80
    s_mul_i32 s47, s47, s59
    s_sub_u32 s53, s47, 115584
    s_brev_b32 s3, 1
    s_cmp_eq_u32 s48, 15
    s_cselect_b32 s47, s3, s47
    s_cmp_eq_u32 s48, 0
    s_cselect_b32 s53, s3, s53
    v_xor_b32 v5, 6, v7
    v_lshl_add_u32 v5, v5, 4, s53
    v_cmp_gt_u32 vcc, 8, v0
    v_lshl_add_u32 v6, v7, 4, s47
    s_cmp_eq_u32 s22, 0
    v_cndmask_b32 v17, v5, v6, vcc
    s_cselect_b64 vcc, -1, 0
    s_mov_b32 m0, s60
    s_mov_b32 s63, s37
    s_waitcnt lgkmcnt(0)
    buffer_load_dwordx4 v16, s[24:27], s63 offen lds
    s_addk_i32 m0, 1024
    s_addk_i32 s63, 28672
    buffer_load_dwordx4 v16, s[24:27], s63 offen lds
    s_addk_i32 m0, 1024
    s_addk_i32 s63, 28672
    buffer_load_dwordx4 v16, s[24:27], s63 offen lds
    s_addk_i32 m0, 1024
    s_addk_i32 s63, 28672
    buffer_load_dwordx4 v16, s[24:27], s63 offen lds
    s_cbranch_vccz L_nh1
    s_movk_i32 m0, 4096
    s_mov_b64 exec, 0xffff
    buffer_load_dwordx4 v17, s[24:27], s37 offen lds
    s_mov_b64 exec, -1
L_nh1:
    s_mov_b32 m0, s58
    s_nop 0
    buffer_load_dwordx4 v20, s[28:31], s38 offen lds
    s_add_u32 m0, m0, s54
    s_add_u32 s38, s38, s49
    buffer_load_dwordx4 v20, s[28:31], s38 offen lds
    s_add_u32 m0, m0, s54
    s_add_u32 s38, s38, s49
    buffer_load_dwordx4 v20, s[28:31], s38 offen lds
    s_add_u32 m0, s58, 2048
    s_xor_b32 s39, s39, 1
    s_mul_i32 s38, s39, 28672
    buffer_load_dwordx4 v20, s[28:31], s38 offen lds
    s_add_u32 m0, m0, s54
    s_add_u32 s38, s38, s49
    buffer_load_dwordx4 v20, s[28:31], s38 offen lds
    s_add_u32 m0, m0, s54
    s_add_u32 s38, s38, s49
    buffer_load_dwordx4 v20, s[28:31], s38 offen lds
    s_load_dwordx8 s[8:15], s[0:1], 16
    s_lshl_b32 s19, s19, 4
    v_xor_b32 v16, s19, v16
    v_xor_b32 v17, s19, v17
    s_abs_i32 s49, s49
    s_movk_i32 s51, 16640
    s_movk_i32 s50, 24832
    s_movk_i32 s43, 5
    s_add_u32 s36, s36, 1
    s_cmp_eq_u32 s36, 7
    s_cselect_b32 s36, 0, s36
    s_lshl_b32 s63, s36, 7
    s_add_u32 s18, s51, s60
    s_mov_b32 m0, s18
    s_lshl_b32 s37, s36, 7
    s_add_u32 s21, s51, 4096
    buffer_load_dwordx4 v16, s[24:27], s63 offen lds
    s_addk_i32 s18, 1024
    s_mov_b32 m0, s18
    s_addk_i32 s63, 28672
    buffer_load_dwordx4 v16, s[24:27], s63 offen lds
    s_addk_i32 s18, 1024
    s_mov_b32 m0, s18
    s_addk_i32 s63, 28672
    s_branch L_ld1
L_ld:
    s_lshl_b32 s63, s36, 7
    s_add_u32 s18, s51, s60
    s_mov_b32 m0, s18
    s_addk_i32 s17, 4096
    s_add_u32 s38, s38, s49
    buffer_load_dwordx4 v16, s[24:27], s63 offen lds
    s_lshl_b32 s37, s36, 7
    s_add_u32 s21, s51, 4096
    s_mov_b32 m0, s17
    s_addk_i32 s18, 1024
    s_addk_i32 s63, 28672
    buffer_load_dwordx4 v20, s[28:31], s38 offen lds
    s_mov_b32 m0, s18
    s_addk_i32 s17, 4096
    s_add_u32 s38, s38, s49
    buffer_load_dwordx4 v16, s[24:27], s63 offen lds
    s_mov_b32 m0, s17
    s_addk_i32 s18, 1024
    s_addk_i32 s63, 28672
    buffer_load_dwordx4 v20, s[28:31], s38 offen lds
    s_mov_b32 m0, s18
    s_waitcnt vmcnt(10)
    s_barrier
L_ld1:
    buffer_load_dwordx4 v16, s[24:27], s63 offen lds
    s_add_u32 s17, s50, s62
    s_mul_i32 s38, s36, 57344
    s_mov_b32 m0, s17
    s_addk_i32 s18, 1024
    s_addk_i32 s63, 28672
    buffer_load_dwordx4 v20, s[28:31], s38 offen lds
    s_add_u32 s36, s36, 1
    s_cmp_eq_u32 s36, 7
    s_cselect_b32 s36, 0, s36
    s_mov_b32 m0, s18
    s_addk_i32 s17, 4096
    s_add_u32 s38, s38, s49
    buffer_load_dwordx4 v16, s[24:27], s63 offen lds
    s_addk_i32 s51, 16640
    s_addk_i32 s50, 24832
    s_cmpk_eq_u32 s51, 49920
    s_cselect_b64 s[50:51], 0, s[50:51]
    s_mov_b32 m0, s17
    s_addk_i32 s18, 1024
    s_addk_i32 s63, 28672
    buffer_load_dwordx4 v20, s[28:31], s38 offen lds
    s_addk_i32 s17, 4096
    s_mov_b32 m0, s17
    s_add_u32 s38, s38, s49
    s_cbranch_vccz L_nhb
    s_mov_b32 m0, s21
    s_mov_b64 exec, 0xffff
    buffer_load_dwordx4 v17, s[24:27], s37 offen lds
    s_mov_b32 m0, s17
    s_mov_b64 exec, -1
    buffer_load_dwordx4 v20, s[28:31], s38 offen lds
    s_addk_i32 s17, -6144
    s_mov_b32 m0, s17
    s_add_u32 s38, s38, 0xfff43000
    s_waitcnt vmcnt(11)
L_ab:
    s_barrier
    buffer_load_dwordx4 v20, s[28:31], s38 offen lds
    s_sub_u32 s43, s43, 1
    s_cbranch_scc0 L_ld
    s_addk_i32 s17, 4096
    s_mov_b32 m0, s17
    s_add_u32 s38, s38, s49
    buffer_load_dwordx4 v20, s[28:31], s38 offen lds
    s_addk_i32 s17, 4096
    s_mov_b32 m0, s17
    s_add_u32 s38, s38, s49
    buffer_load_dwordx4 v20, s[28:31], s38 offen lds
    s_waitcnt vmcnt(8)
    s_barrier
    s_cmp_eq_u32 s22, 3
    s_cbranch_scc1 L_param
    s_waitcnt vmcnt(3)
    s_barrier
    s_waitcnt vmcnt(0)
    s_barrier
    s_endpgm
L_nhb:
    buffer_load_dwordx4 v20, s[28:31], s38 offen lds
    s_addk_i32 s17, -6144
    s_mov_b32 m0, s17
    s_add_u32 s38, s38, 0xfff43000
    s_waitcnt vmcnt(10)
    s_branch L_ab
L_go:
    s_barrier
    ds_read_b64_tr_b16 v[60:61], v14 offset:0
    ds_read_b64_tr_b16 v[62:63], v14 offset:512
    ds_read_b128 v[36:39], v10 offset:4224
    ds_read_b64_tr_b16 v[68:69], v14 offset:4096
    ds_read_b64_tr_b16 v[70:71], v14 offset:4608
    ds_read_b128 v[40:43], v8 offset:0
    ds_read_b64_tr_b16 v[76:77], v14 offset:8192
    ds_read_b64_tr_b16 v[78:79], v14 offset:8704
    ds_read_b128 v[44:47], v8 offset:12544
    ds_read_b128 v[48:51], v8 offset:8448
    s_waitcnt lgkmcnt(7)
    v_mfma_f32_16x16x32_bf16 v[132:135], v[60:63], v[36:39], 0
    s_waitcnt lgkmcnt(4)
    ds_read_b64_tr_b16 v[64:65], v14 offset:8
    v_mfma_f32_16x16x32_bf16 v[132:135], v[68:71], v[40:43], v[132:135]
    s_waitcnt lgkmcnt(2)
    ds_read_b128 v[52:55], v8 offset:4352
    v_mfma_f32_16x16x32_bf16 v[132:135], v[76:79], v[44:47], v[132:135]
    s_waitcnt lgkmcnt(2)
    ds_read_b64_tr_b16 v[66:67], v14 offset:520
    v_mfma_f32_16x16x32_bf16 v[140:143], v[76:79], v[48:51], 0
    ds_read_b128 v[56:59], v9 offset:128
    v_mfma_f32_16x16x32_bf16 v[140:143], v[68:71], v[44:47], v[140:143]
    ds_read_b64_tr_b16 v[72:73], v14 offset:4104
    v_mfma_f32_16x16x32_bf16 v[140:143], v[60:63], v[40:43], v[140:143]
    ds_read_b64_tr_b16 v[74:75], v14 offset:4616
    v_mfma_f32_16x16x32_bf16 v[148:151], v[60:63], v[44:47], 0
    ds_read_b64_tr_b16 v[80:81], v14 offset:8200
    v_mfma_f32_16x16x32_bf16 v[148:151], v[68:71], v[48:51], v[148:151]
    s_waitcnt lgkmcnt(5)
    ds_read_b64_tr_b16 v[82:83], v14 offset:8712
    v_mfma_f32_16x16x32_bf16 v[148:151], v[76:79], v[52:55], v[148:151]
    s_waitcnt lgkmcnt(4)
    v_mfma_f32_16x16x32_bf16 v[156:159], v[76:79], v[56:59], 0
    v_mfma_f32_16x16x32_bf16 v[156:159], v[68:71], v[52:55], v[156:159]
    v_mfma_f32_16x16x32_bf16 v[156:159], v[60:63], v[48:51], v[156:159]
    v_mfma_f32_16x16x32_bf16 v[160:163], v[64:67], v[48:51], 0
    s_waitcnt lgkmcnt(2)
    s_barrier
    v_mfma_f32_16x16x32_bf16 v[160:163], v[72:75], v[52:55], v[160:163]
    s_waitcnt lgkmcnt(0)
    ds_read_b64_tr_b16 v[112:113], v14 offset:2056
    v_mfma_f32_16x16x32_bf16 v[160:163], v[80:83], v[56:59], v[160:163]
    ds_read_b64_tr_b16 v[114:115], v14 offset:2568
    v_mfma_f32_16x16x32_bf16 v[152:155], v[80:83], v[52:55], 0
    ds_read_b128 v[84:87], v13 offset:4224
    v_mfma_f32_16x16x32_bf16 v[152:155], v[72:75], v[48:51], v[152:155]
    ds_read_b64_tr_b16 v[120:121], v14 offset:6152
    v_mfma_f32_16x16x32_bf16 v[152:155], v[64:67], v[44:47], v[152:155]
    ds_read_b64_tr_b16 v[122:123], v14 offset:6664
    v_mfma_f32_16x16x32_bf16 v[144:147], v[64:67], v[40:43], 0
    ds_read_b128 v[88:91], v11 offset:0
    v_mfma_f32_16x16x32_bf16 v[144:147], v[72:75], v[44:47], v[144:147]
    ds_read_b64_tr_b16 v[128:129], v14 offset:10248
    v_mfma_f32_16x16x32_bf16 v[144:147], v[80:83], v[48:51], v[144:147]
    ds_read_b64_tr_b16 v[130:131], v14 offset:10760
    v_mfma_f32_16x16x32_bf16 v[136:139], v[80:83], v[44:47], 0
    ds_read_b128 v[92:95], v11 offset:12544
    v_mfma_f32_16x16x32_bf16 v[136:139], v[72:75], v[40:43], v[136:139]
    ds_read_b128 v[96:99], v11 offset:8448
    v_mfma_f32_16x16x32_bf16 v[136:139], v[64:67], v[36:39], v[136:139]
    s_waitcnt lgkmcnt(7)
    ds_read_b64_tr_b16 v[108:109], v14 offset:2048
    v_mfma_f32_16x16x32_bf16 v[136:139], v[112:115], v[84:87], v[136:139]
    s_waitcnt lgkmcnt(5)
    ds_read_b128 v[100:103], v11 offset:4352
    v_mfma_f32_16x16x32_bf16 v[136:139], v[120:123], v[88:91], v[136:139]
    s_waitcnt lgkmcnt(3)
    ds_read_b64_tr_b16 v[110:111], v14 offset:2560
    v_mfma_f32_16x16x32_bf16 v[136:139], v[128:131], v[92:95], v[136:139]
    s_waitcnt lgkmcnt(3)
    ds_read_b128 v[104:107], v12 offset:128
    v_mfma_f32_16x16x32_bf16 v[144:147], v[128:131], v[96:99], v[144:147]
    ds_read_b64_tr_b16 v[116:117], v14 offset:6144
    v_mfma_f32_16x16x32_bf16 v[144:147], v[120:123], v[92:95], v[144:147]
    ds_read_b64_tr_b16 v[118:119], v14 offset:6656
    v_mfma_f32_16x16x32_bf16 v[144:147], v[112:115], v[88:91], v[144:147]
    ds_read_b64_tr_b16 v[124:125], v14 offset:10240
    v_mfma_f32_16x16x32_bf16 v[152:155], v[112:115], v[92:95], v[152:155]
    ds_read_b64_tr_b16 v[126:127], v14 offset:10752
    v_mfma_f32_16x16x32_bf16 v[152:155], v[120:123], v[96:99], v[152:155]
    s_waitcnt lgkmcnt(6)
    v_mfma_f32_16x16x32_bf16 v[152:155], v[128:131], v[100:103], v[152:155]
    s_waitcnt lgkmcnt(4)
    v_mfma_f32_16x16x32_bf16 v[160:163], v[128:131], v[104:107], v[160:163]
    v_mfma_f32_16x16x32_bf16 v[160:163], v[120:123], v[100:103], v[160:163]
    v_mfma_f32_16x16x32_bf16 v[160:163], v[112:115], v[96:99], v[160:163]
    v_mfma_f32_16x16x32_bf16 v[156:159], v[108:111], v[96:99], v[156:159]
    s_waitcnt lgkmcnt(2)
    s_barrier
    v_mfma_f32_16x16x32_bf16 v[156:159], v[116:119], v[100:103], v[156:159]
    s_waitcnt lgkmcnt(0)
    ds_read_b64_tr_b16 v[60:61], v14 offset:24832
    v_mfma_f32_16x16x32_bf16 v[156:159], v[124:127], v[104:107], v[156:159]
    ds_read_b64_tr_b16 v[62:63], v14 offset:25344
    v_mfma_f32_16x16x32_bf16 v[148:151], v[124:127], v[100:103], v[148:151]
    ds_read_b128 v[36:39], v10 offset:20864
    v_mfma_f32_16x16x32_bf16 v[148:151], v[116:119], v[96:99], v[148:151]
    ds_read_b64_tr_b16 v[68:69], v14 offset:28928
    v_mfma_f32_16x16x32_bf16 v[148:151], v[108:111], v[92:95], v[148:151]
    ds_read_b64_tr_b16 v[70:71], v14 offset:29440
    v_mfma_f32_16x16x32_bf16 v[140:143], v[108:111], v[88:91], v[140:143]
    ds_read_b128 v[40:43], v8 offset:16640
    v_mfma_f32_16x16x32_bf16 v[140:143], v[116:119], v[92:95], v[140:143]
    ds_read_b64_tr_b16 v[76:77], v14 offset:33024
    v_mfma_f32_16x16x32_bf16 v[140:143], v[124:127], v[96:99], v[140:143]
    ds_read_b64_tr_b16 v[78:79], v14 offset:33536
    v_mfma_f32_16x16x32_bf16 v[132:135], v[124:127], v[92:95], v[132:135]
    ds_read_b128 v[44:47], v8 offset:29184
    v_mfma_f32_16x16x32_bf16 v[132:135], v[116:119], v[88:91], v[132:135]
    ds_read_b128 v[48:51], v8 offset:25088
    v_mfma_f32_16x16x32_bf16 v[132:135], v[108:111], v[84:87], v[132:135]
    s_waitcnt lgkmcnt(7)
    ds_read_b64_tr_b16 v[64:65], v14 offset:24840
    v_mfma_f32_16x16x32_bf16 v[132:135], v[60:63], v[36:39], v[132:135]
    s_waitcnt lgkmcnt(5)
    ds_read_b128 v[52:55], v8 offset:20992
    v_mfma_f32_16x16x32_bf16 v[132:135], v[68:71], v[40:43], v[132:135]
    s_waitcnt lgkmcnt(3)
    ds_read_b64_tr_b16 v[66:67], v14 offset:25352
    v_mfma_f32_16x16x32_bf16 v[132:135], v[76:79], v[44:47], v[132:135]
    s_waitcnt lgkmcnt(3)
    ds_read_b128 v[56:59], v9 offset:16768
    v_mfma_f32_16x16x32_bf16 v[140:143], v[76:79], v[48:51], v[140:143]
    ds_read_b64_tr_b16 v[72:73], v14 offset:28936
    v_mfma_f32_16x16x32_bf16 v[140:143], v[68:71], v[44:47], v[140:143]
    ds_read_b64_tr_b16 v[74:75], v14 offset:29448
    v_mfma_f32_16x16x32_bf16 v[140:143], v[60:63], v[40:43], v[140:143]
    ds_read_b64_tr_b16 v[80:81], v14 offset:33032
    v_mfma_f32_16x16x32_bf16 v[148:151], v[60:63], v[44:47], v[148:151]
    ds_read_b64_tr_b16 v[82:83], v14 offset:33544
    v_mfma_f32_16x16x32_bf16 v[148:151], v[68:71], v[48:51], v[148:151]
    s_waitcnt lgkmcnt(6)
    v_mfma_f32_16x16x32_bf16 v[148:151], v[76:79], v[52:55], v[148:151]
    s_waitcnt lgkmcnt(4)
    v_mfma_f32_16x16x32_bf16 v[156:159], v[76:79], v[56:59], v[156:159]
    v_mfma_f32_16x16x32_bf16 v[156:159], v[68:71], v[52:55], v[156:159]
    v_mfma_f32_16x16x32_bf16 v[156:159], v[60:63], v[48:51], v[156:159]
    v_mfma_f32_16x16x32_bf16 v[160:163], v[64:67], v[48:51], v[160:163]
    s_waitcnt lgkmcnt(2)
    s_barrier
    v_mfma_f32_16x16x32_bf16 v[160:163], v[72:75], v[52:55], v[160:163]
    s_waitcnt lgkmcnt(0)
    ds_read_b64_tr_b16 v[112:113], v14 offset:26888
    v_mfma_f32_16x16x32_bf16 v[160:163], v[80:83], v[56:59], v[160:163]
    ds_read_b64_tr_b16 v[114:115], v14 offset:27400
    v_mfma_f32_16x16x32_bf16 v[152:155], v[80:83], v[52:55], v[152:155]
    ds_read_b128 v[84:87], v13 offset:20864
    v_mfma_f32_16x16x32_bf16 v[152:155], v[72:75], v[48:51], v[152:155]
    ds_read_b64_tr_b16 v[120:121], v14 offset:30984
    v_mfma_f32_16x16x32_bf16 v[152:155], v[64:67], v[44:47], v[152:155]
    ds_read_b64_tr_b16 v[122:123], v14 offset:31496
    v_mfma_f32_16x16x32_bf16 v[144:147], v[64:67], v[40:43], v[144:147]
    ds_read_b128 v[88:91], v11 offset:16640
    v_mfma_f32_16x16x32_bf16 v[144:147], v[72:75], v[44:47], v[144:147]
    ds_read_b64_tr_b16 v[128:129], v14 offset:35080
    v_mfma_f32_16x16x32_bf16 v[144:147], v[80:83], v[48:51], v[144:147]
    ds_read_b64_tr_b16 v[130:131], v14 offset:35592
    v_mfma_f32_16x16x32_bf16 v[136:139], v[80:83], v[44:47], v[136:139]
    ds_read_b128 v[92:95], v11 offset:29184
    v_mfma_f32_16x16x32_bf16 v[136:139], v[72:75], v[40:43], v[136:139]
    ds_read_b128 v[96:99], v11 offset:25088
    v_mfma_f32_16x16x32_bf16 v[136:139], v[64:67], v[36:39], v[136:139]
    s_waitcnt lgkmcnt(7)
    ds_read_b64_tr_b16 v[108:109], v14 offset:26880
    v_mfma_f32_16x16x32_bf16 v[136:139], v[112:115], v[84:87], v[136:139]
    s_waitcnt lgkmcnt(5)
    ds_read_b128 v[100:103], v11 offset:20992
    v_mfma_f32_16x16x32_bf16 v[136:139], v[120:123], v[88:91], v[136:139]
    s_waitcnt lgkmcnt(3)
    ds_read_b64_tr_b16 v[110:111], v14 offset:27392
    v_mfma_f32_16x16x32_bf16 v[136:139], v[128:131], v[92:95], v[136:139]
    s_waitcnt lgkmcnt(3)
    ds_read_b128 v[104:107], v12 offset:16768
    v_mfma_f32_16x16x32_bf16 v[144:147], v[128:131], v[96:99], v[144:147]
    ds_read_b64_tr_b16 v[116:117], v14 offset:30976
    v_mfma_f32_16x16x32_bf16 v[144:147], v[120:123], v[92:95], v[144:147]
    ds_read_b64_tr_b16 v[118:119], v14 offset:31488
    v_mfma_f32_16x16x32_bf16 v[144:147], v[112:115], v[88:91], v[144:147]
    ds_read_b64_tr_b16 v[124:125], v14 offset:35072
    v_mfma_f32_16x16x32_bf16 v[152:155], v[112:115], v[92:95], v[152:155]
    ds_read_b64_tr_b16 v[126:127], v14 offset:35584
    v_mfma_f32_16x16x32_bf16 v[152:155], v[120:123], v[96:99], v[152:155]
    s_waitcnt lgkmcnt(6)
    v_mfma_f32_16x16x32_bf16 v[152:155], v[128:131], v[100:103], v[152:155]
    s_waitcnt lgkmcnt(4)
    v_mfma_f32_16x16x32_bf16 v[160:163], v[128:131], v[104:107], v[160:163]
    v_mfma_f32_16x16x32_bf16 v[160:163], v[120:123], v[100:103], v[160:163]
    v_mfma_f32_16x16x32_bf16 v[160:163], v[112:115], v[96:99], v[160:163]
    v_mfma_f32_16x16x32_bf16 v[156:159], v[108:111], v[96:99], v[156:159]
    s_waitcnt lgkmcnt(2)
    s_barrier
    v_mfma_f32_16x16x32_bf16 v[156:159], v[116:119], v[100:103], v[156:159]
    s_waitcnt lgkmcnt(0)
    ds_read_b64_tr_b16 v[60:61], v16 offset:0
    v_mfma_f32_16x16x32_bf16 v[156:159], v[124:127], v[104:107], v[156:159]
    ds_read_b64_tr_b16 v[62:63], v16 offset:512
    v_mfma_f32_16x16x32_bf16 v[148:151], v[124:127], v[100:103], v[148:151]
    ds_read_b128 v[36:39], v10 offset:37504
    v_mfma_f32_16x16x32_bf16 v[148:151], v[116:119], v[96:99], v[148:151]
    ds_read_b64_tr_b16 v[68:69], v16 offset:4096
    v_mfma_f32_16x16x32_bf16 v[148:151], v[108:111], v[92:95], v[148:151]
    ds_read_b64_tr_b16 v[70:71], v16 offset:4608
    v_mfma_f32_16x16x32_bf16 v[140:143], v[108:111], v[88:91], v[140:143]
    ds_read_b128 v[40:43], v8 offset:33280
    v_mfma_f32_16x16x32_bf16 v[140:143], v[116:119], v[92:95], v[140:143]
    ds_read_b64_tr_b16 v[76:77], v16 offset:8192
    v_mfma_f32_16x16x32_bf16 v[140:143], v[124:127], v[96:99], v[140:143]
    ds_read_b64_tr_b16 v[78:79], v16 offset:8704
    v_mfma_f32_16x16x32_bf16 v[132:135], v[124:127], v[92:95], v[132:135]
    ds_read_b128 v[44:47], v8 offset:45824
    v_mfma_f32_16x16x32_bf16 v[132:135], v[116:119], v[88:91], v[132:135]
    ds_read_b128 v[48:51], v8 offset:41728
    v_mfma_f32_16x16x32_bf16 v[132:135], v[108:111], v[84:87], v[132:135]
    s_waitcnt lgkmcnt(7)
    ds_read_b64_tr_b16 v[64:65], v16 offset:8
    v_mfma_f32_16x16x32_bf16 v[132:135], v[60:63], v[36:39], v[132:135]
    s_waitcnt lgkmcnt(5)
    ds_read_b128 v[52:55], v8 offset:37632
    v_mfma_f32_16x16x32_bf16 v[132:135], v[68:71], v[40:43], v[132:135]
    s_waitcnt lgkmcnt(3)
    ds_read_b64_tr_b16 v[66:67], v16 offset:520
    v_mfma_f32_16x16x32_bf16 v[132:135], v[76:79], v[44:47], v[132:135]
    s_waitcnt lgkmcnt(3)
    ds_read_b128 v[56:59], v9 offset:33408
    v_mfma_f32_16x16x32_bf16 v[140:143], v[76:79], v[48:51], v[140:143]
    ds_read_b64_tr_b16 v[72:73], v16 offset:4104
    v_mfma_f32_16x16x32_bf16 v[140:143], v[68:71], v[44:47], v[140:143]
    ds_read_b64_tr_b16 v[74:75], v16 offset:4616
    v_mfma_f32_16x16x32_bf16 v[140:143], v[60:63], v[40:43], v[140:143]
    ds_read_b64_tr_b16 v[80:81], v16 offset:8200
    v_mfma_f32_16x16x32_bf16 v[148:151], v[60:63], v[44:47], v[148:151]
    ds_read_b64_tr_b16 v[82:83], v16 offset:8712
    v_mfma_f32_16x16x32_bf16 v[148:151], v[68:71], v[48:51], v[148:151]
    s_waitcnt lgkmcnt(6)
    v_mfma_f32_16x16x32_bf16 v[148:151], v[76:79], v[52:55], v[148:151]
    s_waitcnt lgkmcnt(4)
    v_mfma_f32_16x16x32_bf16 v[156:159], v[76:79], v[56:59], v[156:159]
    v_mfma_f32_16x16x32_bf16 v[156:159], v[68:71], v[52:55], v[156:159]
    v_mfma_f32_16x16x32_bf16 v[156:159], v[60:63], v[48:51], v[156:159]
    v_mfma_f32_16x16x32_bf16 v[160:163], v[64:67], v[48:51], v[160:163]
    s_waitcnt lgkmcnt(2)
    s_barrier
    v_mfma_f32_16x16x32_bf16 v[160:163], v[72:75], v[52:55], v[160:163]
    s_waitcnt lgkmcnt(0)
    ds_read_b64_tr_b16 v[112:113], v16 offset:2056
    v_mfma_f32_16x16x32_bf16 v[160:163], v[80:83], v[56:59], v[160:163]
    ds_read_b64_tr_b16 v[114:115], v16 offset:2568
    v_mfma_f32_16x16x32_bf16 v[152:155], v[80:83], v[52:55], v[152:155]
    ds_read_b128 v[84:87], v13 offset:37504
    v_mfma_f32_16x16x32_bf16 v[152:155], v[72:75], v[48:51], v[152:155]
    ds_read_b64_tr_b16 v[120:121], v16 offset:6152
    v_mfma_f32_16x16x32_bf16 v[152:155], v[64:67], v[44:47], v[152:155]
    ds_read_b64_tr_b16 v[122:123], v16 offset:6664
    v_mfma_f32_16x16x32_bf16 v[144:147], v[64:67], v[40:43], v[144:147]
    ds_read_b128 v[88:91], v11 offset:33280
    v_mfma_f32_16x16x32_bf16 v[144:147], v[72:75], v[44:47], v[144:147]
    ds_read_b64_tr_b16 v[128:129], v16 offset:10248
    v_mfma_f32_16x16x32_bf16 v[144:147], v[80:83], v[48:51], v[144:147]
    ds_read_b64_tr_b16 v[130:131], v16 offset:10760
    v_mfma_f32_16x16x32_bf16 v[136:139], v[80:83], v[44:47], v[136:139]
    ds_read_b128 v[92:95], v11 offset:45824
    v_mfma_f32_16x16x32_bf16 v[136:139], v[72:75], v[40:43], v[136:139]
    ds_read_b128 v[96:99], v11 offset:41728
    v_mfma_f32_16x16x32_bf16 v[136:139], v[64:67], v[36:39], v[136:139]
    s_waitcnt lgkmcnt(7)
    ds_read_b64_tr_b16 v[108:109], v16 offset:2048
    v_mfma_f32_16x16x32_bf16 v[136:139], v[112:115], v[84:87], v[136:139]
    s_waitcnt lgkmcnt(5)
    ds_read_b128 v[100:103], v11 offset:37632
    v_mfma_f32_16x16x32_bf16 v[136:139], v[120:123], v[88:91], v[136:139]
    s_waitcnt lgkmcnt(3)
    ds_read_b64_tr_b16 v[110:111], v16 offset:2560
    v_mfma_f32_16x16x32_bf16 v[136:139], v[128:131], v[92:95], v[136:139]
    s_waitcnt lgkmcnt(3)
    ds_read_b128 v[104:107], v12 offset:33408
    v_mfma_f32_16x16x32_bf16 v[144:147], v[128:131], v[96:99], v[144:147]
    ds_read_b64_tr_b16 v[116:117], v16 offset:6144
    v_mfma_f32_16x16x32_bf16 v[144:147], v[120:123], v[92:95], v[144:147]
    ds_read_b64_tr_b16 v[118:119], v16 offset:6656
    v_mfma_f32_16x16x32_bf16 v[144:147], v[112:115], v[88:91], v[144:147]
    ds_read_b64_tr_b16 v[124:125], v16 offset:10240
    v_mfma_f32_16x16x32_bf16 v[152:155], v[112:115], v[92:95], v[152:155]
    ds_read_b64_tr_b16 v[126:127], v16 offset:10752
    v_mfma_f32_16x16x32_bf16 v[152:155], v[120:123], v[96:99], v[152:155]
    s_waitcnt lgkmcnt(6)
    v_mfma_f32_16x16x32_bf16 v[152:155], v[128:131], v[100:103], v[152:155]
    s_waitcnt lgkmcnt(4)
    v_mfma_f32_16x16x32_bf16 v[160:163], v[128:131], v[104:107], v[160:163]
    v_mfma_f32_16x16x32_bf16 v[160:163], v[120:123], v[100:103], v[160:163]
    v_mfma_f32_16x16x32_bf16 v[160:163], v[112:115], v[96:99], v[160:163]
    v_mfma_f32_16x16x32_bf16 v[156:159], v[108:111], v[96:99], v[156:159]
    s_waitcnt lgkmcnt(2)
    s_barrier
    v_mfma_f32_16x16x32_bf16 v[156:159], v[116:119], v[100:103], v[156:159]
    s_waitcnt lgkmcnt(0)
    ds_read_b64_tr_b16 v[60:61], v14 offset:0
    v_mfma_f32_16x16x32_bf16 v[156:159], v[124:127], v[104:107], v[156:159]
    ds_read_b64_tr_b16 v[62:63], v14 offset:512
    v_mfma_f32_16x16x32_bf16 v[148:151], v[124:127], v[100:103], v[148:151]
    ds_read_b128 v[36:39], v10 offset:4224
    v_mfma_f32_16x16x32_bf16 v[148:151], v[116:119], v[96:99], v[148:151]
    ds_read_b64_tr_b16 v[68:69], v14 offset:4096
    v_mfma_f32_16x16x32_bf16 v[148:151], v[108:111], v[92:95], v[148:151]
    ds_read_b64_tr_b16 v[70:71], v14 offset:4608
    v_mfma_f32_16x16x32_bf16 v[140:143], v[108:111], v[88:91], v[140:143]
    ds_read_b128 v[40:43], v8 offset:0
    v_mfma_f32_16x16x32_bf16 v[140:143], v[116:119], v[92:95], v[140:143]
    ds_read_b64_tr_b16 v[76:77], v14 offset:8192
    v_mfma_f32_16x16x32_bf16 v[140:143], v[124:127], v[96:99], v[140:143]
    ds_read_b64_tr_b16 v[78:79], v14 offset:8704
    v_mfma_f32_16x16x32_bf16 v[132:135], v[124:127], v[92:95], v[132:135]
    ds_read_b128 v[44:47], v8 offset:12544
    v_mfma_f32_16x16x32_bf16 v[132:135], v[116:119], v[88:91], v[132:135]
    ds_read_b128 v[48:51], v8 offset:8448
    v_mfma_f32_16x16x32_bf16 v[132:135], v[108:111], v[84:87], v[132:135]
    s_waitcnt lgkmcnt(7)
    ds_read_b64_tr_b16 v[64:65], v14 offset:8
    v_mfma_f32_16x16x32_bf16 v[132:135], v[60:63], v[36:39], v[132:135]
    s_waitcnt lgkmcnt(5)
    ds_read_b128 v[52:55], v8 offset:4352
    v_mfma_f32_16x16x32_bf16 v[132:135], v[68:71], v[40:43], v[132:135]
    s_waitcnt lgkmcnt(3)
    ds_read_b64_tr_b16 v[66:67], v14 offset:520
    v_mfma_f32_16x16x32_bf16 v[132:135], v[76:79], v[44:47], v[132:135]
    s_waitcnt lgkmcnt(3)
    ds_read_b128 v[56:59], v9 offset:128
    v_mfma_f32_16x16x32_bf16 v[140:143], v[76:79], v[48:51], v[140:143]
    ds_read_b64_tr_b16 v[72:73], v14 offset:4104
    v_mfma_f32_16x16x32_bf16 v[140:143], v[68:71], v[44:47], v[140:143]
    ds_read_b64_tr_b16 v[74:75], v14 offset:4616
    v_mfma_f32_16x16x32_bf16 v[140:143], v[60:63], v[40:43], v[140:143]
    ds_read_b64_tr_b16 v[80:81], v14 offset:8200
    v_mfma_f32_16x16x32_bf16 v[148:151], v[60:63], v[44:47], v[148:151]
    ds_read_b64_tr_b16 v[82:83], v14 offset:8712
    v_mfma_f32_16x16x32_bf16 v[148:151], v[68:71], v[48:51], v[148:151]
    s_waitcnt lgkmcnt(6)
    v_mfma_f32_16x16x32_bf16 v[148:151], v[76:79], v[52:55], v[148:151]
    s_waitcnt lgkmcnt(4)
    v_mfma_f32_16x16x32_bf16 v[156:159], v[76:79], v[56:59], v[156:159]
    v_mfma_f32_16x16x32_bf16 v[156:159], v[68:71], v[52:55], v[156:159]
    s_branch L_on
L_param:
    v_lshl_add_u32 v3, v0, 1, s52
    v_mov_b64 v[22:23], 0
    v_mov_b64 v[24:25], 0
    s_waitcnt lgkmcnt(0)
    global_load_short_d16_hi v25, v3, s[10:11]
    global_load_short_d16_hi v22, v3, s[12:13]
    global_load_short_d16_hi v24, v3, s[8:9]
    global_load_short_d16_hi v23, v3, s[14:15]
    v_lshlrev_b32 v4, 2, v0
    v_add_u32 v4, 124416, v4
    s_mov_b32 s40, 0xbfb8aa3b
    s_waitcnt vmcnt(7)
    s_barrier
    s_setprio 3
    s_waitcnt vmcnt(0)
    v_add_f32 v21, 0x3727c5ac, v25
    v_cvt_pk_bf16_f32 v21, 0, v21
    v_sqrt_f32 v21, v21
    v_mul_f32 v23, s40, v23
    v_cvt_pk_bf16_f32 v21, 0, v21
    v_rcp_f32 v21, v21
    s_nop 0
    v_cvt_pk_bf16_f32 v21, 0, v21
    v_mul_f32 v21, v22, v21
    v_cvt_pk_bf16_f32 v21, 0, v21
    v_mul_f32 v21, s40, v21
    v_fma_f32 v23, -v24, v21, v23
    ds_write2st64_b32 v4, v21, v23 offset1:1
    s_waitcnt lgkmcnt(0)
    s_barrier
    s_endpgm
.p2alignl 12, 0xbf810000
L_consumer:
    s_load_dwordx2 s[32:33], s[0:1], 48
    s_bfe_u32 s56, s22, 0x10001
    v_and_b32 v1, 15, v0
    s_lshl_b32 s3, s56, 4
    v_or_b32 v1, s3, v1
    v_lshrrev_b32 v2, 4, v0
    v_lshlrev_b32 v5, 7, v1
    v_and_b32 v4, 6, v1
    v_xor_b32 v4, v4, v2
    v_lshl_add_u32 v8, v4, 4, v5
    v_xor_b32 v11, 64, v8
    v_add_u32 v4, 1, v1
    v_and_b32 v4, 6, v4
    v_xor_b32 v4, v4, v2
    v_lshl_add_u32 v9, v4, 4, v5
    v_xor_b32 v12, 64, v9
    v_add_u32 v4, -1, v1
    v_and_b32 v4, 6, v4
    v_xor_b32 v4, v4, v2
    v_lshl_add_u32 v10, v4, 4, v5
    v_xor_b32 v13, 64, v10
    v_bfe_u32 v4, v0, 2, 2
    v_bfe_u32 v5, v0, 5, 1
    v_lshl_add_u32 v5, v5, 3, v4
    v_bfe_u32 v4, v0, 3, 1
    v_xor_b32 v4, s57, v4
    v_lshl_add_u32 v5, v5, 1, v4
    v_and_b32 v4, 3, v0
    v_lshl_add_u32 v5, v5, 2, v4
    v_bfe_u32 v4, v0, 4, 1
    v_mul_u32_u24 v4, 12296, v4
    v_lshl_add_u32 v5, v5, 4, v4
    v_add_u32 v14, 49920, v5
    v_add_u32 v16, 49664, v14
    v_lshl_add_u32 v4, v1, 2, s23
    s_lshl_b32 s60, s57, 6
    s_add_u32 s61, s60, s52
    v_lshl_add_u32 v5, v2, 4, s61
    v_mad_u32_u24 v18, v4, s59, v5
    s_lshl1_add_u32 s60, s60, 124416
    v_lshl_add_u32 v19, v2, 5, s60
    v_lshrrev_b32 v4, 2, v0
    v_and_b32 v5, 3, v0
    s_lshl2_add_u32 s3, s3, s23
    v_lshl_add_u32 v6, v4, 2, s3
    v_lshl_add_u32 v7, v5, 4, s61
    v_mad_u32_u24 v6, v6, s59, v7
    s_lshl_b32 s3, s22, 12
    s_add_u32 s3, s3, 58368
    v_bfe_u32 v4, v0, 3, 2
    v_xor_b32 v4, v4, v0
    v_lshl_add_u32 v3, v4, 4, s3
    v_bfe_u32 v4, v0, 1, 2
    v_xor_b32 v5, v4, v2
    v_and_b32 v4, 15, v0
    v_lshl_add_u32 v5, v4, 2, v5
    v_lshl_add_u32 v7, v5, 4, s3
    s_mov_b32 s34, s26
    s_mov_b32 s35, s27
    s_mov_b32 s40, 0xbfb8aa3b
    s_mov_b32 s41, s40
    s_setprio 1
    s_waitcnt lgkmcnt(0)
    s_branch L_go
.p2alignl 3, 0xbf810000
L_on:
    v_mfma_f32_16x16x32_bf16 v[156:159], v[60:63], v[48:51], v[156:159]
    s_barrier
    v_mfma_f32_16x16x32_bf16 v[160:163], v[64:67], v[48:51], v[160:163]
    s_waitcnt lgkmcnt(2)
    ds_read_b64_tr_b16 v[112:113], v14 offset:2056
    v_mfma_f32_16x16x32_bf16 v[160:163], v[72:75], v[52:55], v[160:163]
    s_waitcnt lgkmcnt(1)
    ds_read_b64_tr_b16 v[114:115], v14 offset:2568
    v_mfma_f32_16x16x32_bf16 v[160:163], v[80:83], v[56:59], v[160:163]
    ds_read_b128 v[84:87], v13 offset:4224
    v_mfma_f32_16x16x32_bf16 v[152:155], v[80:83], v[52:55], v[152:155]
    ds_read_b64_tr_b16 v[120:121], v14 offset:6152
    v_mfma_f32_16x16x32_bf16 v[152:155], v[72:75], v[48:51], v[152:155]
    ds_read_b64_tr_b16 v[122:123], v14 offset:6664
    v_mfma_f32_16x16x32_bf16 v[152:155], v[64:67], v[44:47], v[152:155]
    ds_read_b128 v[88:91], v11 offset:0
    v_mfma_f32_16x16x32_bf16 v[144:147], v[64:67], v[40:43], v[144:147]
    ds_read_b64_tr_b16 v[128:129], v14 offset:10248
    v_mfma_f32_16x16x32_bf16 v[144:147], v[72:75], v[44:47], v[144:147]
    ds_read_b64_tr_b16 v[130:131], v14 offset:10760
    v_mfma_f32_16x16x32_bf16 v[144:147], v[80:83], v[48:51], v[144:147]
    ds_read_b128 v[92:95], v11 offset:12544
    v_mfma_f32_16x16x32_bf16 v[136:139], v[80:83], v[44:47], v[136:139]
    ds_read_b128 v[96:99], v11 offset:8448
    v_mfma_f32_16x16x32_bf16 v[136:139], v[72:75], v[40:43], v[136:139]
    ds_read_b64_tr_b16 v[108:109], v14 offset:2048
    v_mfma_f32_16x16x32_bf16 v[136:139], v[64:67], v[36:39], v[136:139]
    s_waitcnt lgkmcnt(8)
    ds_read_b128 v[100:103], v11 offset:4352
    v_mfma_f32_16x16x32_bf16 v[136:139], v[112:115], v[84:87], v[136:139]
    s_waitcnt lgkmcnt(6)
    ds_read_b64_tr_b16 v[110:111], v14 offset:2560
    v_mfma_f32_16x16x32_bf16 v[136:139], v[120:123], v[88:91], v[136:139]
    s_waitcnt lgkmcnt(4)
    ds_read_b128 v[104:107], v12 offset:128
    v_mfma_f32_16x16x32_bf16 v[136:139], v[128:131], v[92:95], v[136:139]
    s_waitcnt lgkmcnt(4)
    ds_read_b64_tr_b16 v[116:117], v14 offset:6144
    v_mfma_f32_16x16x32_bf16 v[144:147], v[128:131], v[96:99], v[144:147]
    ds_read_b64_tr_b16 v[118:119], v14 offset:6656
    v_mfma_f32_16x16x32_bf16 v[144:147], v[120:123], v[92:95], v[144:147]
    ds_read_b64_tr_b16 v[124:125], v14 offset:10240
    v_mfma_f32_16x16x32_bf16 v[144:147], v[112:115], v[88:91], v[144:147]
    ds_read_b64_tr_b16 v[126:127], v14 offset:10752
    v_mfma_f32_16x16x32_bf16 v[152:155], v[112:115], v[92:95], v[152:155]
    v_mfma_f32_16x16x32_bf16 v[152:155], v[120:123], v[96:99], v[152:155]
    s_waitcnt lgkmcnt(6)
    v_mfma_f32_16x16x32_bf16 v[152:155], v[128:131], v[100:103], v[152:155]
    s_waitcnt lgkmcnt(4)
    v_mfma_f32_16x16x32_bf16 v[160:163], v[128:131], v[104:107], v[160:163]
    v_mfma_f32_16x16x32_bf16 v[160:163], v[120:123], v[100:103], v[160:163]
    s_barrier
    v_mfma_f32_16x16x32_bf16 v[160:163], v[112:115], v[96:99], v[160:163]
    ds_read_b64_tr_b16 v[60:61], v14 offset:24832
    v_mfma_f32_16x16x32_bf16 v[156:159], v[108:111], v[96:99], v[156:159]
    s_waitcnt lgkmcnt(3)
    ds_read_b64_tr_b16 v[62:63], v14 offset:25344
    v_mfma_f32_16x16x32_bf16 v[156:159], v[116:119], v[100:103], v[156:159]
    s_waitcnt lgkmcnt(2)
    ds_read_b128 v[36:39], v10 offset:20864
    v_mfma_f32_16x16x32_bf16 v[156:159], v[124:127], v[104:107], v[156:159]
    ds_read_b64_tr_b16 v[68:69], v14 offset:28928
    v_mfma_f32_16x16x32_bf16 v[148:151], v[124:127], v[100:103], v[148:151]
    ds_read_b64_tr_b16 v[70:71], v14 offset:29440
    v_mfma_f32_16x16x32_bf16 v[148:151], v[116:119], v[96:99], v[148:151]
    ds_read_b128 v[40:43], v8 offset:16640
    v_mfma_f32_16x16x32_bf16 v[148:151], v[108:111], v[92:95], v[148:151]
    ds_read_b64_tr_b16 v[76:77], v14 offset:33024
    v_mfma_f32_16x16x32_bf16 v[140:143], v[108:111], v[88:91], v[140:143]
    ds_read_b64_tr_b16 v[78:79], v14 offset:33536
    v_mfma_f32_16x16x32_bf16 v[140:143], v[116:119], v[92:95], v[140:143]
    ds_read_b128 v[44:47], v8 offset:29184
    v_mfma_f32_16x16x32_bf16 v[140:143], v[124:127], v[96:99], v[140:143]
    ds_read_b128 v[48:51], v8 offset:25088
    v_mfma_f32_16x16x32_bf16 v[132:135], v[124:127], v[92:95], v[132:135]
    ds_read_b64_tr_b16 v[64:65], v14 offset:24840
    v_mfma_f32_16x16x32_bf16 v[132:135], v[116:119], v[88:91], v[132:135]
    ds_read_b128 v[52:55], v8 offset:20992
    v_mfma_f32_16x16x32_bf16 v[132:135], v[108:111], v[84:87], v[132:135]
    s_waitcnt lgkmcnt(9)
    ds_read_b64_tr_b16 v[66:67], v14 offset:25352
    v_mfma_f32_16x16x32_bf16 v[132:135], v[60:63], v[36:39], v[132:135]
    s_waitcnt lgkmcnt(7)
    ds_read_b128 v[56:59], v9 offset:16768
    v_mfma_f32_16x16x32_bf16 v[132:135], v[68:71], v[40:43], v[132:135]
    s_waitcnt lgkmcnt(5)
    ds_read_b64_tr_b16 v[72:73], v14 offset:28936
    v_mfma_f32_16x16x32_bf16 v[132:135], v[76:79], v[44:47], v[132:135]
    s_waitcnt lgkmcnt(5)
    ds_read_b64_tr_b16 v[74:75], v14 offset:29448
    v_mfma_f32_16x16x32_bf16 v[140:143], v[76:79], v[48:51], v[140:143]
    ds_read_b64_tr_b16 v[80:81], v14 offset:33032
    v_mfma_f32_16x16x32_bf16 v[140:143], v[68:71], v[44:47], v[140:143]
    ds_read_b64_tr_b16 v[82:83], v14 offset:33544
    v_mfma_f32_16x16x32_bf16 v[140:143], v[60:63], v[40:43], v[140:143]
    v_mfma_f32_16x16x32_bf16 v[148:151], v[60:63], v[44:47], v[148:151]
    v_mfma_f32_16x16x32_bf16 v[148:151], v[68:71], v[48:51], v[148:151]
    s_waitcnt lgkmcnt(6)
    v_mfma_f32_16x16x32_bf16 v[148:151], v[76:79], v[52:55], v[148:151]
    s_waitcnt lgkmcnt(4)
    v_mfma_f32_16x16x32_bf16 v[156:159], v[76:79], v[56:59], v[156:159]
    s_barrier
    v_mfma_f32_16x16x32_bf16 v[156:159], v[68:71], v[52:55], v[156:159]
    ds_read_b64_tr_b16 v[112:113], v14 offset:26888
    v_mfma_f32_16x16x32_bf16 v[156:159], v[60:63], v[48:51], v[156:159]
    ds_read_b64_tr_b16 v[114:115], v14 offset:27400
    v_mfma_f32_16x16x32_bf16 v[160:163], v[64:67], v[48:51], v[160:163]
    s_waitcnt lgkmcnt(4)
    ds_read_b128 v[84:87], v13 offset:20864
    v_mfma_f32_16x16x32_bf16 v[160:163], v[72:75], v[52:55], v[160:163]
    s_waitcnt lgkmcnt(3)
    ds_read_b64_tr_b16 v[120:121], v14 offset:30984
    v_mfma_f32_16x16x32_bf16 v[160:163], v[80:83], v[56:59], v[160:163]
    ds_read_b64_tr_b16 v[122:123], v14 offset:31496
    v_mfma_f32_16x16x32_bf16 v[152:155], v[80:83], v[52:55], v[152:155]
    ds_read_b128 v[88:91], v11 offset:16640
    v_mfma_f32_16x16x32_bf16 v[152:155], v[72:75], v[48:51], v[152:155]
    ds_read_b64_tr_b16 v[128:129], v14 offset:35080
    v_mfma_f32_16x16x32_bf16 v[152:155], v[64:67], v[44:47], v[152:155]
    ds_read_b64_tr_b16 v[130:131], v14 offset:35592
    v_mfma_f32_16x16x32_bf16 v[144:147], v[64:67], v[40:43], v[144:147]
    ds_read_b128 v[92:95], v11 offset:29184
    v_mfma_f32_16x16x32_bf16 v[144:147], v[72:75], v[44:47], v[144:147]
    ds_read_b128 v[96:99], v11 offset:25088
    v_mfma_f32_16x16x32_bf16 v[144:147], v[80:83], v[48:51], v[144:147]
    ds_read_b64_tr_b16 v[108:109], v14 offset:26880
    v_mfma_f32_16x16x32_bf16 v[136:139], v[80:83], v[44:47], v[136:139]
    ds_read_b128 v[100:103], v11 offset:20992
    v_mfma_f32_16x16x32_bf16 v[136:139], v[72:75], v[40:43], v[136:139]
    ds_read_b64_tr_b16 v[110:111], v14 offset:27392
    v_mfma_f32_16x16x32_bf16 v[136:139], v[64:67], v[36:39], v[136:139]
    s_waitcnt lgkmcnt(10)
    ds_read_b128 v[104:107], v12 offset:16768
    v_mfma_f32_16x16x32_bf16 v[136:139], v[112:115], v[84:87], v[136:139]
    s_waitcnt lgkmcnt(8)
    ds_read_b64_tr_b16 v[116:117], v14 offset:30976
    v_mfma_f32_16x16x32_bf16 v[136:139], v[120:123], v[88:91], v[136:139]
    s_waitcnt lgkmcnt(6)
    ds_read_b64_tr_b16 v[118:119], v14 offset:31488
    v_mfma_f32_16x16x32_bf16 v[136:139], v[128:131], v[92:95], v[136:139]
    s_waitcnt lgkmcnt(6)
    ds_read_b64_tr_b16 v[124:125], v14 offset:35072
    v_mfma_f32_16x16x32_bf16 v[144:147], v[128:131], v[96:99], v[144:147]
    ds_read_b64_tr_b16 v[126:127], v14 offset:35584
    v_mfma_f32_16x16x32_bf16 v[144:147], v[120:123], v[92:95], v[144:147]
    v_mfma_f32_16x16x32_bf16 v[144:147], v[112:115], v[88:91], v[144:147]
    v_mfma_f32_16x16x32_bf16 v[152:155], v[112:115], v[92:95], v[152:155]
    v_mfma_f32_16x16x32_bf16 v[152:155], v[120:123], v[96:99], v[152:155]
    s_waitcnt lgkmcnt(6)
    v_mfma_f32_16x16x32_bf16 v[152:155], v[128:131], v[100:103], v[152:155]
    s_waitcnt lgkmcnt(4)
    s_barrier
    v_mfma_f32_16x16x32_bf16 v[160:163], v[128:131], v[104:107], v[160:163]
    ds_read_b64_tr_b16 v[60:61], v16 offset:0
    v_mfma_f32_16x16x32_bf16 v[160:163], v[120:123], v[100:103], v[160:163]
    ds_read_b64_tr_b16 v[62:63], v16 offset:512
    v_mfma_f32_16x16x32_bf16 v[160:163], v[112:115], v[96:99], v[160:163]
    ds_read_b128 v[36:39], v10 offset:37504
    v_mfma_f32_16x16x32_bf16 v[156:159], v[108:111], v[96:99], v[156:159]
    s_waitcnt lgkmcnt(5)
    ds_read_b64_tr_b16 v[68:69], v16 offset:4096
    v_mfma_f32_16x16x32_bf16 v[156:159], v[116:119], v[100:103], v[156:159]
    s_waitcnt lgkmcnt(4)
    ds_read_b64_tr_b16 v[70:71], v16 offset:4608
    v_mfma_f32_16x16x32_bf16 v[156:159], v[124:127], v[104:107], v[156:159]
    ds_read_b128 v[40:43], v8 offset:33280
    v_mfma_f32_16x16x32_bf16 v[148:151], v[124:127], v[100:103], v[148:151]
    ds_read_b64_tr_b16 v[76:77], v16 offset:8192
    v_mfma_f32_16x16x32_bf16 v[148:151], v[116:119], v[96:99], v[148:151]
    ds_read_b64_tr_b16 v[78:79], v16 offset:8704
    v_mfma_f32_16x16x32_bf16 v[148:151], v[108:111], v[92:95], v[148:151]
    ds_read_b128 v[44:47], v8 offset:45824
    v_mfma_f32_16x16x32_bf16 v[140:143], v[108:111], v[88:91], v[140:143]
    ds_read_b128 v[48:51], v8 offset:41728
    v_mfma_f32_16x16x32_bf16 v[140:143], v[116:119], v[92:95], v[140:143]
    ds_read_b64_tr_b16 v[64:65], v16 offset:8
    v_mfma_f32_16x16x32_bf16 v[140:143], v[124:127], v[96:99], v[140:143]
    ds_read_b128 v[52:55], v8 offset:37632
    v_mfma_f32_16x16x32_bf16 v[132:135], v[124:127], v[92:95], v[132:135]
    ds_read_b64_tr_b16 v[66:67], v16 offset:520
    v_mfma_f32_16x16x32_bf16 v[132:135], v[116:119], v[88:91], v[132:135]
    ds_read_b128 v[56:59], v9 offset:33408
    v_mfma_f32_16x16x32_bf16 v[132:135], v[108:111], v[84:87], v[132:135]
    s_waitcnt lgkmcnt(5)
    ds_read_b64_tr_b16 v[72:73], v16 offset:4104
    v_mfma_f32_16x16x32_bf16 v[132:135], v[60:63], v[36:39], v[132:135]
    ds_read_b64_tr_b16 v[74:75], v16 offset:4616
    v_mfma_f32_16x16x32_bf16 v[132:135], v[68:71], v[40:43], v[132:135]
    ds_read_b64_tr_b16 v[80:81], v16 offset:8200
    v_mfma_f32_16x16x32_bf16 v[132:135], v[76:79], v[44:47], v[132:135]
    s_waitcnt lgkmcnt(7)
    ds_read_b64_tr_b16 v[82:83], v16 offset:8712
    v_mfma_f32_16x16x32_bf16 v[140:143], v[76:79], v[48:51], v[140:143]
    v_mfma_f32_16x16x32_bf16 v[140:143], v[68:71], v[44:47], v[140:143]
    v_mfma_f32_16x16x32_bf16 v[140:143], v[60:63], v[40:43], v[140:143]
    s_waitcnt lgkmcnt(6)
    s_barrier
    v_mfma_f32_16x16x32_bf16 v[148:151], v[60:63], v[44:47], v[148:151]
    ds_read_b64_tr_b16 v[112:113], v16 offset:2056
    v_mfma_f32_16x16x32_bf16 v[148:151], v[68:71], v[48:51], v[148:151]
    ds_read_b64_tr_b16 v[114:115], v16 offset:2568
    v_mfma_f32_16x16x32_bf16 v[148:151], v[76:79], v[52:55], v[148:151]
    s_waitcnt lgkmcnt(6)
    ds_read_b128 v[84:87], v13 offset:37504
    v_mfma_f32_16x16x32_bf16 v[156:159], v[76:79], v[56:59], v[156:159]
    ds_read_b64_tr_b16 v[120:121], v16 offset:6152
    v_mfma_f32_16x16x32_bf16 v[156:159], v[68:71], v[52:55], v[156:159]
    ds_read_b64_tr_b16 v[122:123], v16 offset:6664
    v_mfma_f32_16x16x32_bf16 v[156:159], v[60:63], v[48:51], v[156:159]
    s_waitcnt lgkmcnt(5)
    ds_read_b128 v[88:91], v11 offset:33280
    v_mfma_f32_16x16x32_bf16 v[160:163], v[64:67], v[48:51], v[160:163]
    ds_read_b64_tr_b16 v[128:129], v16 offset:10248
    v_mfma_f32_16x16x32_bf16 v[160:163], v[72:75], v[52:55], v[160:163]
    ds_read_b64_tr_b16 v[130:131], v16 offset:10760
    v_mfma_f32_16x16x32_bf16 v[160:163], v[80:83], v[56:59], v[160:163]
    ds_read_b128 v[92:95], v11 offset:45824
    v_mfma_f32_16x16x32_bf16 v[152:155], v[80:83], v[52:55], v[152:155]
    ds_read_b128 v[96:99], v11 offset:41728
    v_mfma_f32_16x16x32_bf16 v[152:155], v[72:75], v[48:51], v[152:155]
    ds_read_b64_tr_b16 v[108:109], v16 offset:2048
    v_mfma_f32_16x16x32_bf16 v[152:155], v[64:67], v[44:47], v[152:155]
    ds_read_b128 v[100:103], v11 offset:37632
    v_mfma_f32_16x16x32_bf16 v[144:147], v[64:67], v[40:43], v[144:147]
    ds_read_b64_tr_b16 v[110:111], v16 offset:2560
    v_mfma_f32_16x16x32_bf16 v[144:147], v[72:75], v[44:47], v[144:147]
    ds_read_b128 v[104:107], v12 offset:33408
    v_mfma_f32_16x16x32_bf16 v[144:147], v[80:83], v[48:51], v[144:147]
    ds_read_b64_tr_b16 v[116:117], v16 offset:6144
    v_mfma_f32_16x16x32_bf16 v[136:139], v[80:83], v[44:47], v[136:139]
    ds_read_b64_tr_b16 v[118:119], v16 offset:6656
    v_mfma_f32_16x16x32_bf16 v[136:139], v[72:75], v[40:43], v[136:139]
    ds_read_b64_tr_b16 v[124:125], v16 offset:10240
    v_mfma_f32_16x16x32_bf16 v[136:139], v[64:67], v[36:39], v[136:139]
    s_waitcnt lgkmcnt(8)
    ds_read_b64_tr_b16 v[126:127], v16 offset:10752
    v_mfma_f32_16x16x32_bf16 v[136:139], v[112:115], v[84:87], v[136:139]
    s_waitcnt lgkmcnt(4)
    s_barrier
    v_mfma_f32_16x16x32_bf16 v[136:139], v[120:123], v[88:91], v[136:139]
    ds_read_b64_tr_b16 v[60:61], v14 offset:0
    v_mfma_f32_16x16x32_bf16 v[136:139], v[128:131], v[92:95], v[136:139]
    ds_read_b64_tr_b16 v[62:63], v14 offset:512
    v_mfma_f32_16x16x32_bf16 v[144:147], v[128:131], v[96:99], v[144:147]
    ds_read_b128 v[36:39], v10 offset:4224
    v_mfma_f32_16x16x32_bf16 v[144:147], v[120:123], v[92:95], v[144:147]
    ds_read_b64_tr_b16 v[68:69], v14 offset:4096
    v_mfma_f32_16x16x32_bf16 v[144:147], v[112:115], v[88:91], v[144:147]
    ds_read_b64_tr_b16 v[70:71], v14 offset:4608
    v_mfma_f32_16x16x32_bf16 v[152:155], v[112:115], v[92:95], v[152:155]
    ds_read_b128 v[40:43], v8 offset:0
    v_mfma_f32_16x16x32_bf16 v[152:155], v[120:123], v[96:99], v[152:155]
    ds_read_b64_tr_b16 v[76:77], v14 offset:8192
    v_mfma_f32_16x16x32_bf16 v[152:155], v[128:131], v[100:103], v[152:155]
    ds_read_b64_tr_b16 v[78:79], v14 offset:8704
    v_mfma_f32_16x16x32_bf16 v[160:163], v[128:131], v[104:107], v[160:163]
    ds_read_b128 v[44:47], v8 offset:12544
    v_mfma_f32_16x16x32_bf16 v[160:163], v[120:123], v[100:103], v[160:163]
    ds_read_b64_tr_b16 v[80:81], v14 offset:8200
    v_mfma_f32_16x16x32_bf16 v[160:163], v[112:115], v[96:99], v[160:163]
    s_waitcnt lgkmcnt(10)
    ds_read_b64_tr_b16 v[82:83], v14 offset:8712
    v_mfma_f32_16x16x32_bf16 v[156:159], v[108:111], v[96:99], v[156:159]
    ds_read_b64_tr_b16 v[72:73], v14 offset:4104
    v_mfma_f32_16x16x32_bf16 v[156:159], v[116:119], v[100:103], v[156:159]
    ds_read_b64_tr_b16 v[74:75], v14 offset:4616
    v_mfma_f32_16x16x32_bf16 v[156:159], v[124:127], v[104:107], v[156:159]
    ds_read_b64_tr_b16 v[64:65], v14 offset:8
    v_mfma_f32_16x16x32_bf16 v[148:151], v[124:127], v[100:103], v[148:151]
    ds_read_b64_tr_b16 v[66:67], v14 offset:520
    v_mfma_f32_16x16x32_bf16 v[148:151], v[116:119], v[96:99], v[148:151]
    ds_read_b128 v[48:51], v8 offset:8448
    v_mfma_f32_16x16x32_bf16 v[148:151], v[108:111], v[92:95], v[148:151]
    ds_read_b128 v[52:55], v8 offset:4352
    v_mfma_f32_16x16x32_bf16 v[140:143], v[108:111], v[88:91], v[140:143]
    ds_read_b128 v[56:59], v9 offset:128
    v_mfma_f32_16x16x32_bf16 v[140:143], v[116:119], v[92:95], v[140:143]
    ds_read_b128 v[200:203], v13 offset:4224
    v_mfma_f32_16x16x32_bf16 v[140:143], v[124:127], v[96:99], v[140:143]
    ds_read_b128 v[204:207], v11 offset:0
    v_mfma_f32_16x16x32_bf16 v[132:135], v[124:127], v[92:95], v[132:135]
    ds_read_b128 v[208:211], v11 offset:12544
    v_mfma_f32_16x16x32_bf16 v[132:135], v[116:119], v[88:91], v[132:135]
    ds_read_b128 v[212:215], v11 offset:8448
    v_mfma_f32_16x16x32_bf16 v[132:135], v[108:111], v[84:87], v[132:135]
    s_waitcnt lgkmcnt(13)
    ds_read_b128 v[216:219], v11 offset:4352
    v_mfma_f32_16x16x32_bf16 v[132:135], v[60:63], v[36:39], v[132:135]
    s_barrier
    v_mfma_f32_16x16x32_bf16 v[132:135], v[68:71], v[40:43], v[132:135]
    ds_read_b64_tr_b16 v[108:109], v14 offset:2048
    ds_read_b64_tr_b16 v[110:111], v14 offset:2560
    v_mfma_f32_16x16x32_bf16 v[132:135], v[76:79], v[44:47], v[132:135]
    s_waitcnt lgkmcnt(9)
    ds_read_b64_tr_b16 v[116:117], v14 offset:6144
    ds_read_b64_tr_b16 v[118:119], v14 offset:6656
    v_mfma_f32_16x16x32_bf16 v[136:139], v[80:83], v[44:47], v[136:139]
    ds_read_b64_tr_b16 v[124:125], v14 offset:10240
    ds_read_b64_tr_b16 v[126:127], v14 offset:10752
    v_mfma_f32_16x16x32_bf16 v[136:139], v[72:75], v[40:43], v[136:139]
    ds_read_b128 v[164:167], v19 offset:0
    v_mfma_f32_16x16x32_bf16 v[136:139], v[64:67], v[36:39], v[136:139]
    ds_read_b128 v[172:175], v19 offset:256
    v_mfma_f32_16x16x32_bf16 v[144:147], v[64:67], v[40:43], v[144:147]
    ds_read_b128 v[220:223], v12 offset:128
    v_mfma_f32_16x16x32_bf16 v[144:147], v[72:75], v[44:47], v[144:147]
    ds_read_b64_tr_b16 v[112:113], v14 offset:2056
    v_mfma_f32_16x16x32_bf16 v[144:147], v[80:83], v[48:51], v[144:147]
    s_waitcnt lgkmcnt(4)
    ds_read_b64_tr_b16 v[114:115], v14 offset:2568
    v_mfma_f32_16x16x32_bf16 v[132:135], v[108:111], v[200:203], v[132:135]
    ds_read_b64_tr_b16 v[120:121], v14 offset:6152
    v_mfma_f32_16x16x32_bf16 v[132:135], v[116:119], v[204:207], v[132:135]
    ds_read_b64_tr_b16 v[122:123], v14 offset:6664
    v_mfma_f32_16x16x32_bf16 v[132:135], v[124:127], v[208:211], v[132:135]
    ds_read_b64_tr_b16 v[128:129], v14 offset:10248
    v_mfma_f32_16x16x32_bf16 v[140:143], v[76:79], v[48:51], v[140:143]
    ds_read_b64_tr_b16 v[130:131], v14 offset:10760
    v_mfma_f32_16x16x32_bf16 v[140:143], v[68:71], v[44:47], v[140:143]
    ds_read_b128 v[168:171], v19 offset:16
    v_mfma_f32_16x16x32_bf16 v[140:143], v[60:63], v[40:43], v[140:143]
    ds_read_b128 v[176:179], v19 offset:272
    v_mfma_f32_16x16x32_bf16 v[140:143], v[108:111], v[204:207], v[140:143]
    s_waitcnt lgkmcnt(9)
    v_fma_f32 v132, v132, v164, v172
    v_fma_f32 v133, v133, v165, v173
    v_mfma_f32_16x16x32_bf16 v[140:143], v[116:119], v[208:211], v[140:143]
    v_exp_f32 v20, v132
    v_mfma_f32_16x16x32_bf16 v[140:143], v[124:127], v[212:215], v[140:143]
    v_exp_f32 v21, v133
    v_mfma_f32_16x16x32_bf16 v[148:151], v[60:63], v[44:47], v[148:151]
    v_fma_f32 v134, v134, v166, v174
    v_fma_f32 v135, v135, v167, v175
    v_mfma_f32_16x16x32_bf16 v[148:151], v[68:71], v[48:51], v[148:151]
    v_exp_f32 v22, v134
    v_mfma_f32_16x16x32_bf16 v[148:151], v[76:79], v[52:55], v[148:151]
    s_waitcnt lgkmcnt(2)
    v_exp_f32 v23, v135
    v_mfma_f32_16x16x32_bf16 v[136:139], v[112:115], v[200:203], v[136:139]
    v_fma_f32 v20, v20, s40, s40
    v_fma_f32 v21, v21, s40, s40
    v_mfma_f32_16x16x32_bf16 v[136:139], v[120:123], v[204:207], v[136:139]
    v_rcp_f32 v20, v20
    v_mfma_f32_16x16x32_bf16 v[136:139], v[128:131], v[208:211], v[136:139]
    v_rcp_f32 v21, v21
    v_mfma_f32_16x16x32_bf16 v[144:147], v[128:131], v[212:215], v[144:147]
    v_fma_f32 v22, v22, s40, s40
    v_fma_f32 v23, v23, s40, s40
    v_mfma_f32_16x16x32_bf16 v[144:147], v[120:123], v[208:211], v[144:147]
    v_rcp_f32 v22, v22
    v_mfma_f32_16x16x32_bf16 v[144:147], v[112:115], v[204:207], v[144:147]
    v_rcp_f32 v23, v23
    v_mfma_f32_16x16x32_bf16 v[152:155], v[112:115], v[208:211], v[152:155]
    v_mul_f32 v132, v132, v20
    v_mul_f32 v133, v133, v21
    v_mfma_f32_16x16x32_bf16 v[152:155], v[120:123], v[212:215], v[152:155]
    v_mul_f32 v134, v134, v22
    v_mul_f32 v135, v135, v23
    v_mfma_f32_16x16x32_bf16 v[152:155], v[128:131], v[216:219], v[152:155]
    v_cvt_pk_bf16_f32 v180, v132, v133
    v_cvt_pk_bf16_f32 v181, v134, v135
    v_mfma_f32_16x16x32_bf16 v[152:155], v[64:67], v[44:47], v[152:155]
    s_waitcnt lgkmcnt(0)
    v_fma_f32 v136, v136, v168, v176
    v_fma_f32 v137, v137, v169, v177
    v_mfma_f32_16x16x32_bf16 v[152:155], v[72:75], v[48:51], v[152:155]
    v_exp_f32 v24, v136
    v_mfma_f32_16x16x32_bf16 v[152:155], v[80:83], v[52:55], v[152:155]
    v_exp_f32 v25, v137
    v_mfma_f32_16x16x32_bf16 v[148:151], v[108:111], v[208:211], v[148:151]
    v_fma_f32 v138, v138, v170, v178
    v_fma_f32 v139, v139, v171, v179
    v_mfma_f32_16x16x32_bf16 v[148:151], v[116:119], v[212:215], v[148:151]
    v_exp_f32 v26, v138
    v_mfma_f32_16x16x32_bf16 v[148:151], v[124:127], v[216:219], v[148:151]
    v_exp_f32 v27, v139
    v_mfma_f32_16x16x32_bf16 v[156:159], v[124:127], v[220:223], v[156:159]
    v_fma_f32 v24, v24, s40, s40
    v_fma_f32 v25, v25, s40, s40
    v_mfma_f32_16x16x32_bf16 v[156:159], v[116:119], v[216:219], v[156:159]
    v_rcp_f32 v24, v24
    v_mfma_f32_16x16x32_bf16 v[156:159], v[108:111], v[212:215], v[156:159]
    v_rcp_f32 v25, v25
    v_mfma_f32_16x16x32_bf16 v[156:159], v[60:63], v[48:51], v[156:159]
    v_fma_f32 v26, v26, s40, s40
    v_fma_f32 v27, v27, s40, s40
    v_mfma_f32_16x16x32_bf16 v[156:159], v[68:71], v[52:55], v[156:159]
    v_rcp_f32 v26, v26
    v_mfma_f32_16x16x32_bf16 v[156:159], v[76:79], v[56:59], v[156:159]
    v_rcp_f32 v27, v27
    v_mfma_f32_16x16x32_bf16 v[160:163], v[80:83], v[56:59], v[160:163]
    v_mul_f32 v136, v136, v24
    v_mul_f32 v137, v137, v25
    v_mfma_f32_16x16x32_bf16 v[160:163], v[72:75], v[52:55], v[160:163]
    v_mul_f32 v138, v138, v26
    v_mul_f32 v139, v139, v27
    v_mfma_f32_16x16x32_bf16 v[160:163], v[64:67], v[48:51], v[160:163]
    v_cvt_pk_bf16_f32 v182, v136, v137
    v_cvt_pk_bf16_f32 v183, v138, v139
    v_mfma_f32_16x16x32_bf16 v[160:163], v[112:115], v[212:215], v[160:163]
    buffer_store_dwordx4 v[180:183], v18, s[32:35], 0 offen offset:0 sc1
    v_mfma_f32_16x16x32_bf16 v[160:163], v[120:123], v[216:219], v[160:163]
    v_fma_f32 v140, v140, v164, v172
    v_fma_f32 v141, v141, v165, v173
    v_mfma_f32_16x16x32_bf16 v[160:163], v[128:131], v[220:223], v[160:163]
    v_exp_f32 v20, v140
    v_exp_f32 v21, v141
    v_pk_fma_f32 v[142:143], v[142:143], v[166:167], v[174:175]
    v_pk_fma_f32 v[20:21], v[20:21], s[40:41], s[40:41]
    v_rcp_f32 v20, v20
    v_rcp_f32 v21, v21
    v_exp_f32 v22, v142
    v_pk_mul_f32 v[140:141], v[140:141], v[20:21]
    v_exp_f32 v23, v143
    v_cvt_pk_bf16_f32 v184, v140, v141
    v_pk_fma_f32 v[22:23], v[22:23], s[40:41], s[40:41]
    v_rcp_f32 v22, v22
    v_pk_fma_f32 v[144:145], v[144:145], v[168:169], v[176:177]
    v_rcp_f32 v23, v23
    v_exp_f32 v24, v144
    v_pk_mul_f32 v[142:143], v[142:143], v[22:23]
    v_exp_f32 v25, v145
    v_cvt_pk_bf16_f32 v185, v142, v143
    v_pk_fma_f32 v[24:25], v[24:25], s[40:41], s[40:41]
    v_rcp_f32 v24, v24
    v_pk_fma_f32 v[146:147], v[146:147], v[170:171], v[178:179]
    v_rcp_f32 v25, v25
    v_exp_f32 v26, v146
    v_pk_mul_f32 v[144:145], v[144:145], v[24:25]
    v_exp_f32 v27, v147
    v_cvt_pk_bf16_f32 v186, v144, v145
    v_pk_fma_f32 v[26:27], v[26:27], s[40:41], s[40:41]
    v_rcp_f32 v26, v26
    v_pk_fma_f32 v[148:149], v[148:149], v[164:165], v[172:173]
    v_rcp_f32 v27, v27
    v_exp_f32 v28, v148
    v_pk_mul_f32 v[146:147], v[146:147], v[26:27]
    v_exp_f32 v29, v149
    v_cvt_pk_bf16_f32 v187, v146, v147
    v_pk_fma_f32 v[28:29], v[28:29], s[40:41], s[40:41]
    buffer_store_dwordx4 v[184:187], v18, s[32:35], 0 offen offset:896 sc1
    v_rcp_f32 v28, v28
    v_pk_fma_f32 v[150:151], v[150:151], v[166:167], v[174:175]
    v_rcp_f32 v29, v29
    v_exp_f32 v30, v150
    v_pk_mul_f32 v[148:149], v[148:149], v[28:29]
    v_exp_f32 v31, v151
    v_cvt_pk_bf16_f32 v188, v148, v149
    v_pk_fma_f32 v[30:31], v[30:31], s[40:41], s[40:41]
    v_rcp_f32 v30, v30
    v_pk_fma_f32 v[152:153], v[152:153], v[168:169], v[176:177]
    v_rcp_f32 v31, v31
    v_exp_f32 v32, v152
    v_pk_mul_f32 v[150:151], v[150:151], v[30:31]
    v_exp_f32 v33, v153
    v_cvt_pk_bf16_f32 v189, v150, v151
    v_pk_fma_f32 v[32:33], v[32:33], s[40:41], s[40:41]
    v_rcp_f32 v32, v32
    v_pk_fma_f32 v[154:155], v[154:155], v[170:171], v[178:179]
    v_rcp_f32 v33, v33
    v_exp_f32 v34, v154
    v_pk_mul_f32 v[152:153], v[152:153], v[32:33]
    v_exp_f32 v35, v155
    v_cvt_pk_bf16_f32 v190, v152, v153
    v_pk_fma_f32 v[34:35], v[34:35], s[40:41], s[40:41]
    v_rcp_f32 v34, v34
    v_pk_fma_f32 v[156:157], v[156:157], v[164:165], v[172:173]
    v_rcp_f32 v35, v35
    v_exp_f32 v20, v156
    v_pk_mul_f32 v[154:155], v[154:155], v[34:35]
    v_exp_f32 v21, v157
    v_cvt_pk_bf16_f32 v191, v154, v155
    v_pk_fma_f32 v[20:21], v[20:21], s[40:41], s[40:41]
    buffer_store_dwordx4 v[188:191], v18, s[32:35], 0 offen offset:1792 sc1
    v_rcp_f32 v20, v20
    v_pk_fma_f32 v[158:159], v[158:159], v[166:167], v[174:175]
    v_rcp_f32 v21, v21
    v_exp_f32 v22, v158
    v_pk_mul_f32 v[156:157], v[156:157], v[20:21]
    v_exp_f32 v23, v159
    v_cvt_pk_bf16_f32 v192, v156, v157
    v_pk_fma_f32 v[22:23], v[22:23], s[40:41], s[40:41]
    v_rcp_f32 v22, v22
    v_pk_fma_f32 v[160:161], v[160:161], v[168:169], v[176:177]
    v_rcp_f32 v23, v23
    v_exp_f32 v24, v160
    v_pk_mul_f32 v[158:159], v[158:159], v[22:23]
    v_exp_f32 v25, v161
    v_cvt_pk_bf16_f32 v193, v158, v159
    v_pk_fma_f32 v[24:25], v[24:25], s[40:41], s[40:41]
    v_rcp_f32 v24, v24
    v_pk_fma_f32 v[162:163], v[162:163], v[170:171], v[178:179]
    v_rcp_f32 v25, v25
    v_exp_f32 v26, v162
    v_pk_mul_f32 v[160:161], v[160:161], v[24:25]
    v_exp_f32 v27, v163
    v_cvt_pk_bf16_f32 v194, v160, v161
    v_pk_fma_f32 v[26:27], v[26:27], s[40:41], s[40:41]
    v_rcp_f32 v26, v26
    v_rcp_f32 v27, v27
    s_nop 0
    v_pk_mul_f32 v[162:163], v[162:163], v[26:27]
    v_cvt_pk_bf16_f32 v195, v162, v163
    ds_write_b128 v7, v[192:195] offset:3072
    ds_read_b128 v[192:195], v3 offset:3072
    s_waitcnt lgkmcnt(0)
    buffer_store_dwordx4 v[192:195], v6, s[32:35], 0 offen offset:2688 sc1
L_end:
    s_endpgm
L_hp2:
    s_cmp_lg_u32 s22, 5
    s_cbranch_scc1 L_hp3
    s_lshl3_add_u32 s3, s5, 16
    s_load_dwordx2 s[8:9], s[0:1], s3
    v_min_u32 v0, 6, v0
    v_lshlrev_b32 v0, 7, v0
    s_waitcnt lgkmcnt(0)
    global_load_dword v1, v0, s[8:9]
L_hp3:
    s_endpgm
.p2alignl 12, 0xbf810000
.section .rodata,"a"
.p2align 6
.amdhsa_kernel standalone__batchnorm__prompt_kernel
  .amdhsa_next_free_vgpr 224
  .amdhsa_next_free_sgpr 64
  .amdhsa_accum_offset 224
  .amdhsa_group_segment_fixed_size 0
  .amdhsa_kernarg_size 72
  .amdhsa_user_sgpr_count 2
  .amdhsa_user_sgpr_kernarg_segment_ptr 1
  .amdhsa_system_sgpr_workgroup_id_x 1
.end_amdhsa_kernel
```
